```python
import torch

def _softmax(x, axis=-1):
    return torch.softmax(x, dim=axis)
def _gelu(x):
    return torch.nn.functional.gelu(x, approximate="tanh")
def _silu(x):
    return torch.nn.functional.silu(x)
def _sigmoid(x):
    return torch.sigmoid(x)
def _layernorm(x, axis=-1, eps=1e-5):
    m = x.mean(dim=axis, keepdim=True)
    v = x.var(dim=axis, keepdim=True, unbiased=False)
    return (x - m) / torch.sqrt(v + eps)
def _scatter_add(tgt, idx, src, axis=0):
    return tgt.clone().index_add_(axis, idx, src)
def _segment_sum(src, seg, n):
    out = torch.zeros((n,) + src.shape[1:], dtype=src.dtype)
    return out.index_add_(0, seg, src)
def _pad(x, pw):
    flat = tuple(v for pair in reversed(pw) for v in pair)
    return torch.nn.functional.pad(x, flat)

kernel_name = 'standalone__paged_block_table_kv_pagedattention__decode'

def setup_inputs():

    _w = (lambda a: (lambda t: t.to(torch.bfloat16) if t.is_floating_point() else t)(torch.as_tensor(a)))
    B, Hq, Hkv, Sq, Skv, D = 4, 32, 8, 1, 4096, 128
    bs = 16
    nbps = max(1, Skv // bs)
    num_phys = B * nbps + 4
    bt = torch.randperm(num_phys)[: B * nbps].reshape(B, nbps).to(torch.int64)
    cl = (nbps * bs - (torch.arange(1, B + 1, dtype=torch.int64) * 2654435761) % max(1, nbps * bs // 2)).to(torch.int64)
    return {
        "q": _w((lambda *s: torch.randn(*s, dtype=torch.bfloat16) * 0.8)(B, Hq, Sq, D)),
        "k_cache": _w((lambda *s: torch.randn(*s, dtype=torch.bfloat16) * 0.8)(num_phys, bs, Hkv, D)),
        "v_cache": _w((lambda *s: torch.randn(*s, dtype=torch.bfloat16) * 0.05)(num_phys, bs, Hkv, D)),
        "block_table": _w(bt),
        "context_lens": _w(cl),
    }

def reference(q, k_cache, v_cache, block_table, context_lens):
    B, Hq, Sq, D = q.shape
    bs = k_cache.shape[1]
    Hkv = k_cache.shape[2]
    nbps = block_table.shape[1]
    Skv = nbps * bs
    bt = block_table.reshape(-1)
    k = (lambda x, *d: x.permute(*d))(k_cache[bt].reshape(B, Skv, Hkv, D), 0, 2, 1, 3)
    v = (lambda x, *d: x.permute(*d))(v_cache[bt].reshape(B, Skv, Hkv, D), 0, 2, 1, 3)
    g = Hq // Hkv
    qg = q.reshape(B, Hkv, g, Sq, D)
    scores = torch.einsum("bhgqd,bhkd->bhgqk", qg, k) * (D ** -0.5)
    pos = torch.arange(Skv)
    msk = pos[None, :] < context_lens[:, None]
    scores = torch.where(msk[:, None, None, None, :], scores, -1e9)
    p = _softmax(scores, axis=-1)
    out = torch.einsum("bhgqk,bhkd->bhgqd", p, v)
    return out.reshape(B, Hq, Sq, D)
```

```asm
; @launch grid=(256,1,1) block=(256,1,1) lds=16896
.amdgcn_target "amdgcn-amd-amdhsa--gfx950"
.text
.globl standalone__paged_block_table_kv_pagedattention__decode_kernel
.p2align 8
.type standalone__paged_block_table_kv_pagedattention__decode_kernel,@function
standalone__paged_block_table_kv_pagedattention__decode_kernel:
  s_cmpk_ge_u32 s2, 256
  s_cbranch_scc1 L_end
  s_load_dwordx16 s[4:19], s[0:1], 0
  v_lshrrev_b32 v36, 6, v0
  s_lshr_b32 s42, s2, 3
  v_readfirstlane_b32 s40, v36
  s_lshl_b32 s41, s2, 2
  s_lshr_b32 s41, 0x64372501, s41
  s_and_b32 s41, s41, 7
  s_cmp_eq_u32 s40, 3
  s_cselect_b64 exec, 0, -1
  s_cbranch_execz L_pad0
L_back0:
  s_mov_b64 exec, -1
  s_lshl2_add_u32 s70, s42, s40
  s_movk_i32 s74, 156
  s_cmpk_ge_u32 s70, 39
  s_cselect_b32 s74, 0x36488, s74
  s_cmpk_ge_u32 s70, 73
  s_cselect_b32 s74, 0x6dc78, s74
  s_cmpk_ge_u32 s70, 103
  s_cselect_b32 s74, 0xa6464, s74
  s_lshr_b32 s71, s74, 8
  s_and_b32 s45, s74, 0xff
  s_lshl2_add_u32 s59, s70, s71
  s_add_u32 s58, s59, s45
  s_add_u32 s57, s58, s45
  s_add_u32 s56, s57, s45
  s_add_u32 s55, s56, s45
  s_add_u32 s54, s55, s45
  s_bitcmp1_b32 s2, 2
  s_cselect_b32 s74, 30, 14
  v_and_b32 v12, s74, v0
  v_lshlrev_b32 v12, 10, v12
  v_and_b32 v38, 1, v0
  s_lshl_b32 s74, s70, 7
  s_add_u32 s74, s74, s41
  v_lshl_add_u32 v12, v38, 7, v12
  v_lshl_add_u32 v12, s74, 8, v12
  s_waitcnt lgkmcnt(0)
  s_load_dword s48, s[10:11], s54
  s_load_dword s49, s[10:11], s55
  s_load_dword s50, s[10:11], s56
  s_load_dword s51, s[10:11], s57
  s_load_dword s52, s[10:11], s58
  s_load_dword s53, s[10:11], s59
  s_load_dwordx4 s[64:67], s[12:13], 0
  global_load_dword v78, v12, s[6:7]
L_chunk1_end:
  v_and_b32 v1, 63, v0
  s_lshr_b32 s44, s59, 10
  v_lshrrev_b32 v6, 2, v1
  v_and_b32 v36, 3, v1
L_pad0:
  s_cbranch_execz L_back0
  s_lshl3_add_u32 s74, s44, s41
  s_lshl_b32 s74, s74, 10
  v_lshlrev_b32 v39, 4, v6
  v_lshl_add_u32 v39, v36, 8, v39
  v_add_u32 v39, s74, v39
  global_load_dwordx4 v[20:23], v39, s[4:5]
  v_lshrrev_b32 v37, 4, v1
  v_and_b32 v3, 3, v6
  v_lshlrev_b32 v2, 13, v3
  v_lshl_add_u32 v2, v37, 6, v2
  v_lshl_add_u32 v2, v36, 4, v2
  v_lshl_add_u32 v2, s41, 8, v2
  v_add_u32 v3, 0x1000, v2
  s_mov_b32 s20, s6
  s_mov_b32 s21, s7
  s_mov_b32 s22, 33685504
  s_mov_b32 s23, 0x20000
  s_lshl_b32 s43, s42, 2
  s_lshl_b32 s47, s44, 10
  s_lshl2_add_u32 s74, s43, s71
  s_cmp_lt_i32 s74, s47
  s_cselect_b32 s46, 1, 0
  s_add_u32 s47, s47, 4
  s_mov_b32 s76, 0
  s_cmp_eq_u32 s40, 3
  s_cbranch_scc1 L_open
L_first:
  s_bitcmp1_b32 s44, 0
  s_waitcnt lgkmcnt(0)
  s_cselect_b32 s70, s67, s66
  s_cselect_b32 s66, s65, s64
  s_bitcmp1_b32 s44, 1
  s_cselect_b32 s66, s70, s66
L_round:
  s_setprio 3
  s_sub_u32 s70, s66, 1
  s_min_u32 s79, s70, 4095
  s_lshr_b32 s70, s79, 4
  s_lshl2_add_u32 s75, s70, s47
  s_lshl_b32 s48, s48, 15
  s_cmp_lt_u32 s54, s75
  s_cselect_b32 s48, s48, 1073741824
  buffer_load_dwordx4 a[0:3], v2, s[20:23], s48 offen offset:0 nt
  buffer_load_dwordx4 a[4:7], v2, s[20:23], s48 offen offset:2048 nt
  buffer_load_dwordx4 a[8:11], v3, s[20:23], s48 offen offset:0 nt
  buffer_load_dwordx4 a[12:15], v3, s[20:23], s48 offen offset:2048 nt
  s_lshl_b32 s49, s49, 15
  s_cmp_lt_u32 s55, s75
  s_cselect_b32 s49, s49, 1073741824
  buffer_load_dwordx4 a[16:19], v2, s[20:23], s49 offen offset:0 nt
  buffer_load_dwordx4 a[20:23], v2, s[20:23], s49 offen offset:2048 nt
  buffer_load_dwordx4 a[24:27], v3, s[20:23], s49 offen offset:0 nt
  buffer_load_dwordx4 a[28:31], v3, s[20:23], s49 offen offset:2048 nt
  s_lshl_b32 s50, s50, 15
  s_cmp_lt_u32 s56, s75
  s_cselect_b32 s50, s50, 1073741824
  buffer_load_dwordx4 a[32:35], v2, s[20:23], s50 offen offset:0 nt
  buffer_load_dwordx4 a[36:39], v2, s[20:23], s50 offen offset:2048 nt
  buffer_load_dwordx4 a[40:43], v3, s[20:23], s50 offen offset:0 nt
  buffer_load_dwordx4 a[44:47], v3, s[20:23], s50 offen offset:2048 nt
  s_lshl_b32 s51, s51, 15
  s_cmp_lt_u32 s57, s75
  s_cselect_b32 s51, s51, 1073741824
  buffer_load_dwordx4 a[48:51], v2, s[20:23], s51 offen offset:0 nt
  buffer_load_dwordx4 a[52:55], v2, s[20:23], s51 offen offset:2048 nt
  buffer_load_dwordx4 a[56:59], v3, s[20:23], s51 offen offset:0 nt
  buffer_load_dwordx4 a[60:63], v3, s[20:23], s51 offen offset:2048 nt
  s_lshl_b32 s52, s52, 15
  s_cmp_lt_u32 s58, s75
  s_cselect_b32 s52, s52, 1073741824
  buffer_load_dwordx4 a[64:67], v2, s[20:23], s52 offen offset:0 nt
  buffer_load_dwordx4 a[68:71], v2, s[20:23], s52 offen offset:2048 nt
  buffer_load_dwordx4 a[72:75], v3, s[20:23], s52 offen offset:0 nt
  buffer_load_dwordx4 a[76:79], v3, s[20:23], s52 offen offset:2048 nt
  s_lshl_b32 s53, s53, 15
  s_cmp_lt_u32 s59, s75
  s_cselect_b32 s53, s53, 1073741824
  buffer_load_dwordx4 a[80:83], v2, s[20:23], s53 offen offset:0 nt
  buffer_load_dwordx4 a[84:87], v2, s[20:23], s53 offen offset:2048 nt
  buffer_load_dwordx4 a[88:91], v3, s[20:23], s53 offen offset:0 nt
  buffer_load_dwordx4 a[92:95], v3, s[20:23], s53 offen offset:2048 nt
  s_cmp_lg_u32 s76, 0
  s_cbranch_scc1 L_setup_done
  s_branch L_setup
L_open:
  s_mov_b32 s28, s18
  s_mov_b32 s29, s19
  s_mov_b32 s30, 2228224
  s_mov_b32 s31, 0x20000
  s_lshl_b32 s70, s41, 5
  s_add_u32 s70, s70, s42
  s_mul_i32 s60, s70, 8704
  v_lshlrev_b32 v10, 4, v1
  v_lshl_add_u32 v38, v6, 26, v10
  v_mov_b32 v80, -1
  v_mov_b32 v81, -1
  v_mov_b32 v82, -1
  v_mov_b32 v83, -1
  s_add_u32 s61, s60, 4352
  s_bitcmp1_b32 0x2040200, s42
  s_cselect_b32 s61, s61, 1073741824
  buffer_store_dwordx4 v[80:83], v10, s[28:31], s60 offen
  buffer_store_dwordx4 v[80:83], v10, s[28:31], s60 offen offset:1024
  buffer_store_dwordx4 v[80:83], v38, s[28:31], s60 offen offset:2048
  buffer_store_dwordx4 v[80:83], v10, s[28:31], s61 offen
  buffer_store_dwordx4 v[80:83], v10, s[28:31], s61 offen offset:1024
  buffer_store_dwordx4 v[80:83], v38, s[28:31], s61 offen offset:2048
  s_getreg_b32 s78, hwreg(HW_REG_XCC_ID, 0, 4)
  s_or_b32 s78, s78, 0x80
  v_mov_b32 v30, s78
  v_mov_b32 v31, s70
  s_mov_b64 exec, 1
  s_waitcnt vmcnt(0)
  global_store_byte v31, v30, s[16:17]
  s_mov_b64 exec, -1
  s_branch L_first
L_setup:
  s_mov_b32 s24, s8
  s_mov_b32 s25, s9
  s_mov_b32 s26, 33685504
  s_mov_b32 s27, 0x20000
  s_mov_b32 s28, s18
  s_mov_b32 s29, s19
  s_mov_b32 s30, 2228224
  s_mov_b32 s31, 0x20000
  s_mov_b32 s32, s16
  s_mov_b32 s33, s17
  s_movk_i32 s34, 256
  s_mov_b32 s35, 0x20000
  s_mov_b32 s36, s14
  s_mov_b32 s37, s15
  s_mov_b32 s38, 32768
  s_mov_b32 s39, 0x20000
  v_and_b32 v38, 15, v1
  v_lshlrev_b32 v4, 13, v37
  v_lshl_add_u32 v4, v38, 4, v4
  v_lshl_add_u32 v4, s41, 8, v4
  v_add_u32 v5, 0x1000, v4
  v_lshlrev_b32 v10, 4, v1
  v_min_u32 v11, 1, v1
  v_lshlrev_b32 v11, 30, v11
  v_lshrrev_b32 v79, 5, v1
  v_lshl_add_u32 v79, v79, 30, v1
  v_mov_b32 v45, 1
  v_mov_b32 v7, 0xfe967699
  v_mov_b32 v8, 0xf149f2ca
  v_mov_b32 v9, 0
  v_mov_b32 v48, 0
  v_mov_b32 v49, 0
  v_mov_b32 v50, 0
  v_mov_b32 v51, 0
  v_mov_b32 v52, 0
  v_mov_b32 v53, 0
  v_mov_b32 v54, 0
  v_mov_b32 v55, 0
  v_mov_b32 v56, 0
  v_mov_b32 v57, 0
  v_mov_b32 v58, 0
  v_mov_b32 v59, 0
  v_mov_b32 v60, 0
  v_mov_b32 v61, 0
  v_mov_b32 v62, 0
  v_mov_b32 v63, 0
  v_mov_b32 v64, 0
  v_mov_b32 v65, 0
  v_mov_b32 v66, 0
  v_mov_b32 v67, 0
  v_mov_b32 v68, 0
  v_mov_b32 v69, 0
  v_mov_b32 v70, 0
  v_mov_b32 v71, 0
  s_mov_b32 s68, 0x05040100
  s_mov_b32 s69, 0x07060302
  s_mov_b32 s72, 0
  s_mov_b32 s73, -1
  s_mov_b32 s67, 0x3e0293ee
  s_cmp_gt_i32 s66, 0
  s_cselect_b32 s67, s67, 0
  s_getreg_b32 s78, hwreg(HW_REG_XCC_ID, 0, 4)
  s_or_b32 s78, s78, 0x80
  s_lshl_b32 s9, s41, 5
  s_lshl_b32 s70, s46, 6
  s_lshl2_add_u32 s70, s40, s70
  v_lshl_add_u32 v13, v36, 4, s70
  v_xor_b32 v39, 64, v13
  ds_write2_b32 v39, v7, v9 offset0:0 offset1:32
  s_lshl_b32 s70, s46, 13
  s_lshl_b32 s71, s40, 11
  s_add_u32 s70, s70, s71
  s_xor_b32 s71, s70, 0x2000
  v_add_u32 v39, s71, v10
  ds_write_b128 v39, v[48:51] offset:512
  ds_write_b128 v39, v[48:51] offset:1536
  s_add_u32 s70, s70, 512
  v_lshlrev_b32 v14, 4, v38
  v_lshl_add_u32 v14, v37, 2, v14
  v_add_u32 v14, s70, v14
  s_add_u32 s70, s9, s42
  s_mul_i32 s4, s70, 8704
  s_add_u32 s5, s4, 4352
  s_mov_b32 s44, 0
  s_mov_b32 s6, 0x3ff
  s_mov_b32 s7, 0x7fe00
  s_cmp_gt_u32 s42, 9
  s_cselect_b32 s44, 1, s44
  s_cselect_b32 s6, s7, s6
  s_cselect_b32 s7, 0x3fc0000, s7
  s_cmp_gt_u32 s42, 18
  s_cselect_b32 s44, 2, s44
  s_cselect_b32 s6, s7, s6
  s_cselect_b32 s7, 0xfe000000, s7
  s_cmp_gt_u32 s42, 25
  s_cselect_b32 s44, 3, s44
  s_cselect_b32 s6, s7, s6
  s_bitcmp1_b32 0x2040200, s42
  s_cselect_b32 s7, s7, s6
  s_cselect_b32 s12, 1, 0
  s_cselect_b32 s18, s5, 1073741824
  s_cselect_b32 s46, 1, 0
  s_cmp_lg_u32 s40, 3
  s_cselect_b32 s46, 1, s46
  s_ff1_i32_b32 s71, s6
  s_sub_u32 s65, s42, s71
  s_add_u32 s70, s40, 1
  s_cmp_eq_u32 s65, s70
  s_cselect_b32 s77, 1, 0
  s_add_u32 s71, s71, s9
  s_mul_i32 s60, s71, 8704
  s_lshl3_add_u32 s70, s44, s41
  s_lshl_b32 s8, s70, 10
  s_bcnt1_i32_b32 s74, s6
  v_and_b32 v39, 31, v1
  s_lshl_b32 s70, s40, 9
  v_lshl_add_u32 v15, v39, 4, s70
  s_lshl_b32 s71, s40, 4
  v_mov_b32 v16, s71
  s_add_u32 s71, s71, 2048
  v_mov_b32 v17, 1073741824
  v_mov_b32 v30, s71
  v_cmp_eq_u32 vcc, 32, v1
  v_lshrrev_b32 v31, 5, v1
  v_lshlrev_b32 v18, 4, v38
  v_cndmask_b32 v17, v17, v30, vcc
  v_cndmask_b32 v17, v15, v17, s[72:73]
  v_and_b32 v39, 1, v37
  v_lshl_add_u32 v18, v39, 3, v18
  v_lshl_add_u32 v18, v31, 2, v18
  v_lshl_add_u32 v18, s40, 8, v18
  s_bfm_b32 s70, s74, 0
  s_bitset0_b32 s70, s65
  s_add_u32 s61, s60, 17408
  s_add_u32 s62, s60, 34816
  s_add_u32 s63, s60, 52224
  s_add_u32 s64, s60, 69632
  v_lshrrev_b32 v30, v31, s70
  v_mul_u32_u24 v39, 8704, v31
  v_add_u32 v39, v39, v15
  v_mov_b32 v38, 1073741824
  v_bfe_i32 v40, v30, 0, 1
  v_bfi_b32 v40, v40, v39, v38
  v_bfe_i32 v41, v30, 2, 1
  v_bfi_b32 v41, v41, v39, v38
  v_bfe_i32 v42, v30, 4, 1
  v_bfi_b32 v42, v42, v39, v38
  v_bfe_i32 v43, v30, 6, 1
  v_bfi_b32 v43, v43, v39, v38
  v_bfe_i32 v44, v30, 8, 1
  v_bfi_b32 v44, v44, v39, v38
  s_cmp_lg_u32 s44, 0
  s_cselect_b32 s44, 4352, 0
  v_add_u32 v30, s44, v40
  v_cndmask_b32 v40, v30, v40, s[72:73]
  v_and_b32 v39, 7, v1
  v_lshl_add_u32 v39, v39, 1, v31
  v_lshrrev_b32 v30, v39, s70
  v_and_b32 v30, 1, v30
  v_cmp_eq_u32 s[14:15], 1, v30
  v_cmp_eq_u32 s[16:17], s65, v39
  v_mov_b32 v19, 1.0
  v_cndmask_b32 v19, v19, 0, s[72:73]
  v_cmp_eq_u32 vcc, 0, v39
  v_mul_u32_u24 v35, 8704, v39
  v_add_u32 v35, s71, v35
  v_add_u32 v30, s44, v35
  v_cndmask_b32 v35, v35, v30, vcc
  v_cndmask_b32 v35, v38, v35, s[14:15]
L_setup_done:
  s_setprio 0
  s_waitcnt vmcnt(20)
  v_mfma_f32_16x16x32_bf16 v[80:83], a[0:3], v[20:23], 0
  v_mfma_f32_16x16x32_bf16 v[84:87], a[4:7], v[20:23], 0
  v_mfma_f32_16x16x32_bf16 v[88:91], a[8:11], v[20:23], 0
  v_mfma_f32_16x16x32_bf16 v[92:95], a[12:15], v[20:23], 0
  buffer_load_dwordx4 v[112:115], v4, s[24:27], s48 offen offset:0 nt
  buffer_load_dwordx4 v[128:131], v4, s[24:27], s49 offen offset:0 nt
  s_waitcnt vmcnt(18)
  v_mfma_f32_16x16x32_bf16 v[96:99], a[16:19], v[20:23], 0
  v_mfma_f32_16x16x32_bf16 v[100:103], a[20:23], v[20:23], 0
  v_mfma_f32_16x16x32_bf16 v[104:107], a[24:27], v[20:23], 0
  v_mfma_f32_16x16x32_bf16 v[108:111], a[28:31], v[20:23], 0
  s_sub_u32 s70, s54, s47
  s_lshl_b32 s70, s70, 2
  s_sub_u32 s70, s79, s70
  s_sub_u32 s70, s70, 15
  v_add_f32_dpp v30, v81, v80 row_shl:4 row_mask:0xf bank_mask:0x1
  v_add_f32_dpp v30, v84, v85 row_shr:4 row_mask:0xf bank_mask:0x2
  v_add_f32_dpp v30, v83, v82 row_shl:4 row_mask:0xf bank_mask:0x4
  v_add_f32_dpp v30, v86, v87 row_shr:4 row_mask:0xf bank_mask:0x8
  v_add_f32_dpp v31, v89, v88 row_shl:4 row_mask:0xf bank_mask:0x1
  v_add_f32_dpp v31, v92, v93 row_shr:4 row_mask:0xf bank_mask:0x2
  v_add_f32_dpp v31, v91, v90 row_shl:4 row_mask:0xf bank_mask:0x4
  v_add_f32_dpp v31, v94, v95 row_shr:4 row_mask:0xf bank_mask:0x8
  v_add_f32_dpp v24, v30, v30 row_shl:8 row_mask:0xf bank_mask:0x3
  v_cmp_gt_i32 vcc, s70, v6
  v_add_f32_dpp v24, v31, v31 row_shr:8 row_mask:0xf bank_mask:0xc
  v_mul_f32 v24, s67, v24
  v_cndmask_b32 v24, v7, v24, vcc
  buffer_load_dwordx4 v[116:119], v4, s[24:27], s48 offen offset:2048 nt
  buffer_load_dwordx4 v[132:135], v4, s[24:27], s49 offen offset:2048 nt
  s_waitcnt vmcnt(16)
  v_mfma_f32_16x16x32_bf16 v[80:83], a[32:35], v[20:23], 0
  v_mfma_f32_16x16x32_bf16 v[84:87], a[36:39], v[20:23], 0
  v_mfma_f32_16x16x32_bf16 v[88:91], a[40:43], v[20:23], 0
  v_mfma_f32_16x16x32_bf16 v[92:95], a[44:47], v[20:23], 0
  s_sub_u32 s70, s55, s47
  s_lshl_b32 s70, s70, 2
  s_sub_u32 s70, s79, s70
  s_sub_u32 s70, s70, 15
  v_add_f32_dpp v30, v97, v96 row_shl:4 row_mask:0xf bank_mask:0x1
  v_add_f32_dpp v30, v100, v101 row_shr:4 row_mask:0xf bank_mask:0x2
  v_add_f32_dpp v30, v99, v98 row_shl:4 row_mask:0xf bank_mask:0x4
  v_add_f32_dpp v30, v102, v103 row_shr:4 row_mask:0xf bank_mask:0x8
  v_add_f32_dpp v31, v105, v104 row_shl:4 row_mask:0xf bank_mask:0x1
  v_add_f32_dpp v31, v108, v109 row_shr:4 row_mask:0xf bank_mask:0x2
  v_add_f32_dpp v31, v107, v106 row_shl:4 row_mask:0xf bank_mask:0x4
  v_add_f32_dpp v31, v110, v111 row_shr:4 row_mask:0xf bank_mask:0x8
  v_add_f32_dpp v25, v30, v30 row_shl:8 row_mask:0xf bank_mask:0x3
  v_cmp_gt_i32 vcc, s70, v6
  v_add_f32_dpp v25, v31, v31 row_shr:8 row_mask:0xf bank_mask:0xc
  v_mul_f32 v25, s67, v25
  v_cndmask_b32 v25, v7, v25, vcc
  buffer_load_dwordx4 v[120:123], v5, s[24:27], s48 offen offset:0 nt
  buffer_load_dwordx4 v[136:139], v5, s[24:27], s49 offen offset:0 nt
  s_waitcnt vmcnt(14)
  v_mfma_f32_16x16x32_bf16 v[96:99], a[48:51], v[20:23], 0
  v_mfma_f32_16x16x32_bf16 v[100:103], a[52:55], v[20:23], 0
  v_mfma_f32_16x16x32_bf16 v[104:107], a[56:59], v[20:23], 0
  v_mfma_f32_16x16x32_bf16 v[108:111], a[60:63], v[20:23], 0
  s_sub_u32 s70, s56, s47
  s_lshl_b32 s70, s70, 2
  s_sub_u32 s70, s79, s70
  s_sub_u32 s70, s70, 15
  v_add_f32_dpp v30, v81, v80 row_shl:4 row_mask:0xf bank_mask:0x1
  v_add_f32_dpp v30, v84, v85 row_shr:4 row_mask:0xf bank_mask:0x2
  v_add_f32_dpp v30, v83, v82 row_shl:4 row_mask:0xf bank_mask:0x4
  v_add_f32_dpp v30, v86, v87 row_shr:4 row_mask:0xf bank_mask:0x8
  v_add_f32_dpp v31, v89, v88 row_shl:4 row_mask:0xf bank_mask:0x1
  v_add_f32_dpp v31, v92, v93 row_shr:4 row_mask:0xf bank_mask:0x2
  v_add_f32_dpp v31, v91, v90 row_shl:4 row_mask:0xf bank_mask:0x4
  v_add_f32_dpp v31, v94, v95 row_shr:4 row_mask:0xf bank_mask:0x8
  v_add_f32_dpp v26, v30, v30 row_shl:8 row_mask:0xf bank_mask:0x3
  v_cmp_gt_i32 vcc, s70, v6
  v_add_f32_dpp v26, v31, v31 row_shr:8 row_mask:0xf bank_mask:0xc
  v_mul_f32 v26, s67, v26
  v_cndmask_b32 v26, v7, v26, vcc
  buffer_load_dwordx4 v[124:127], v5, s[24:27], s48 offen offset:2048 nt
  buffer_load_dwordx4 v[140:143], v5, s[24:27], s49 offen offset:2048 nt
  s_waitcnt vmcnt(12)
  v_mfma_f32_16x16x32_bf16 v[80:83], a[64:67], v[20:23], 0
  v_mfma_f32_16x16x32_bf16 v[84:87], a[68:71], v[20:23], 0
  v_mfma_f32_16x16x32_bf16 v[88:91], a[72:75], v[20:23], 0
  v_mfma_f32_16x16x32_bf16 v[92:95], a[76:79], v[20:23], 0
  s_sub_u32 s70, s57, s47
  s_lshl_b32 s70, s70, 2
  s_sub_u32 s70, s79, s70
  s_sub_u32 s70, s70, 15
  v_add_f32_dpp v30, v97, v96 row_shl:4 row_mask:0xf bank_mask:0x1
  v_add_f32_dpp v30, v100, v101 row_shr:4 row_mask:0xf bank_mask:0x2
  v_add_f32_dpp v30, v99, v98 row_shl:4 row_mask:0xf bank_mask:0x4
  v_add_f32_dpp v30, v102, v103 row_shr:4 row_mask:0xf bank_mask:0x8
  v_add_f32_dpp v31, v105, v104 row_shl:4 row_mask:0xf bank_mask:0x1
  v_add_f32_dpp v31, v108, v109 row_shr:4 row_mask:0xf bank_mask:0x2
  v_add_f32_dpp v31, v107, v106 row_shl:4 row_mask:0xf bank_mask:0x4
  v_add_f32_dpp v31, v110, v111 row_shr:4 row_mask:0xf bank_mask:0x8
  v_add_f32_dpp v27, v30, v30 row_shl:8 row_mask:0xf bank_mask:0x3
  v_cmp_gt_i32 vcc, s70, v6
  v_add_f32_dpp v27, v31, v31 row_shr:8 row_mask:0xf bank_mask:0xc
  v_mul_f32 v27, s67, v27
  v_cndmask_b32 v27, v7, v27, vcc
  buffer_load_dwordx4 v[144:147], v4, s[24:27], s50 offen offset:0 nt
  buffer_load_dwordx4 v[160:163], v4, s[24:27], s51 offen offset:0 nt
  s_waitcnt vmcnt(10)
  v_mfma_f32_16x16x32_bf16 v[96:99], a[80:83], v[20:23], 0
  v_mfma_f32_16x16x32_bf16 v[100:103], a[84:87], v[20:23], 0
  v_mfma_f32_16x16x32_bf16 v[104:107], a[88:91], v[20:23], 0
  v_mfma_f32_16x16x32_bf16 v[108:111], a[92:95], v[20:23], 0
  s_sub_u32 s70, s58, s47
  s_lshl_b32 s70, s70, 2
  s_sub_u32 s70, s79, s70
  s_sub_u32 s70, s70, 15
  v_add_f32_dpp v30, v81, v80 row_shl:4 row_mask:0xf bank_mask:0x1
  v_add_f32_dpp v30, v84, v85 row_shr:4 row_mask:0xf bank_mask:0x2
  v_add_f32_dpp v30, v83, v82 row_shl:4 row_mask:0xf bank_mask:0x4
  v_add_f32_dpp v30, v86, v87 row_shr:4 row_mask:0xf bank_mask:0x8
  v_add_f32_dpp v31, v89, v88 row_shl:4 row_mask:0xf bank_mask:0x1
  v_add_f32_dpp v31, v92, v93 row_shr:4 row_mask:0xf bank_mask:0x2
  v_add_f32_dpp v31, v91, v90 row_shl:4 row_mask:0xf bank_mask:0x4
  v_add_f32_dpp v31, v94, v95 row_shr:4 row_mask:0xf bank_mask:0x8
  v_add_f32_dpp v28, v30, v30 row_shl:8 row_mask:0xf bank_mask:0x3
  v_cmp_gt_i32 vcc, s70, v6
  v_add_f32_dpp v28, v31, v31 row_shr:8 row_mask:0xf bank_mask:0xc
  v_mul_f32 v28, s67, v28
  v_cndmask_b32 v28, v7, v28, vcc
  buffer_load_dwordx4 v[148:151], v4, s[24:27], s50 offen offset:2048 nt
  buffer_load_dwordx4 v[164:167], v4, s[24:27], s51 offen offset:2048 nt
  s_sub_u32 s70, s59, s47
  s_lshl_b32 s70, s70, 2
  s_sub_u32 s70, s79, s70
  s_sub_u32 s70, s70, 15
  v_add_f32_dpp v30, v97, v96 row_shl:4 row_mask:0xf bank_mask:0x1
  v_add_f32_dpp v30, v100, v101 row_shr:4 row_mask:0xf bank_mask:0x2
  v_add_f32_dpp v30, v99, v98 row_shl:4 row_mask:0xf bank_mask:0x4
  v_add_f32_dpp v30, v102, v103 row_shr:4 row_mask:0xf bank_mask:0x8
  v_add_f32_dpp v31, v105, v104 row_shl:4 row_mask:0xf bank_mask:0x1
  v_add_f32_dpp v31, v108, v109 row_shr:4 row_mask:0xf bank_mask:0x2
  v_add_f32_dpp v31, v107, v106 row_shl:4 row_mask:0xf bank_mask:0x4
  v_add_f32_dpp v31, v110, v111 row_shr:4 row_mask:0xf bank_mask:0x8
  v_add_f32_dpp v29, v30, v30 row_shl:8 row_mask:0xf bank_mask:0x3
  v_cmp_gt_i32 vcc, s70, v6
  v_add_f32_dpp v29, v31, v31 row_shr:8 row_mask:0xf bank_mask:0xc
  v_mul_f32 v29, s67, v29
  v_cndmask_b32 v29, v7, v29, vcc
  v_max3_f32 v36, v24, v25, v26
  v_max3_f32 v36, v36, v27, v28
  v_max3_f32 v36, v36, v29, v8
  s_nop 1
  v_max_f32_dpp v36, v36, v36 row_ror:4 row_mask:0xf bank_mask:0xf
  s_nop 1
  v_max_f32_dpp v36, v36, v36 row_ror:8 row_mask:0xf bank_mask:0xf
  v_mov_b32 v37, v36
  s_nop 1
  v_permlane16_swap_b32 v36, v37
  v_max_f32 v36, v36, v37
  v_mov_b32 v37, v36
  s_nop 1
  v_permlane32_swap_b32 v36, v37
  v_max_f32 v36, v36, v37
  s_cmp_eq_u32 s76, 0
  s_cbranch_scc0 L_rescale
L_rescale_done:
  v_mov_b32 v8, v36
  v_sub_f32 v24, v24, v36
  v_sub_f32 v25, v25, v36
  v_sub_f32 v26, v26, v36
  v_sub_f32 v27, v27, v36
  v_sub_f32 v28, v28, v36
  v_sub_f32 v29, v29, v36
  v_exp_f32 v24, v24
  v_exp_f32 v25, v25
  v_exp_f32 v26, v26
  v_exp_f32 v27, v27
  v_exp_f32 v28, v28
  v_exp_f32 v29, v29
  s_nop 0
  v_cvt_pk_bf16_f32 v32, v24, v25
  v_cvt_pk_bf16_f32 v33, v26, v27
  v_cvt_pk_bf16_f32 v34, v28, v29
  v_add_f32 v9, v9, v24
  v_add_f32 v9, v9, v25
  v_add_f32 v9, v9, v26
  v_add_f32 v9, v9, v27
  v_add_f32 v9, v9, v28
  v_add_f32 v9, v9, v29
  v_mov_b32 v38, v9
  v_mov_b32_dpp v48, v32 quad_perm:[0,1,2,3] row_mask:0xf bank_mask:0x1
  v_mov_b32_dpp v49, v32 row_shl:4 row_mask:0xf bank_mask:0x1
  v_add_f32_dpp v38, v38, v38 row_ror:4 row_mask:0xf bank_mask:0xf
  v_mov_b32_dpp v50, v32 row_shl:8 row_mask:0xf bank_mask:0x1
  v_mov_b32_dpp v51, v32 row_shl:12 row_mask:0xf bank_mask:0x1
  v_add_f32_dpp v38, v38, v38 row_ror:8 row_mask:0xf bank_mask:0xf
  v_mov_b32 v37, v38
  v_mov_b32_dpp v52, v32 row_shr:4 row_mask:0xf bank_mask:0x2
  v_mov_b32_dpp v53, v32 quad_perm:[0,1,2,3] row_mask:0xf bank_mask:0x2
  v_permlane16_swap_b32 v38, v37
  v_add_f32 v38, v38, v37
  v_mov_b32 v37, v38
  v_mov_b32_dpp v54, v32 row_shl:4 row_mask:0xf bank_mask:0x2
  v_mov_b32_dpp v55, v32 row_shl:8 row_mask:0xf bank_mask:0x2
  v_permlane32_swap_b32 v38, v37
  v_add_f32 v38, v38, v37
  v_mov_b32_dpp v56, v32 row_shr:8 row_mask:0xf bank_mask:0x4
  v_mov_b32_dpp v57, v32 row_shr:4 row_mask:0xf bank_mask:0x4
  v_mov_b32_dpp v58, v32 quad_perm:[0,1,2,3] row_mask:0xf bank_mask:0x4
  v_mov_b32_dpp v59, v32 row_shl:4 row_mask:0xf bank_mask:0x4
  v_mov_b32_dpp v60, v32 row_shr:12 row_mask:0xf bank_mask:0x8
  v_mov_b32_dpp v61, v32 row_shr:8 row_mask:0xf bank_mask:0x8
  v_mov_b32_dpp v62, v32 row_shr:4 row_mask:0xf bank_mask:0x8
  v_mov_b32_dpp v63, v32 quad_perm:[0,1,2,3] row_mask:0xf bank_mask:0x8
  ds_write2_b32 v13, v8, v38 offset0:0 offset1:32
  buffer_load_dwordx4 v[152:155], v5, s[24:27], s50 offen offset:0 nt
  buffer_load_dwordx4 v[168:171], v5, s[24:27], s51 offen offset:0 nt
  buffer_load_dwordx4 v[156:159], v5, s[24:27], s50 offen offset:2048 nt
  buffer_load_dwordx4 v[172:175], v5, s[24:27], s51 offen offset:2048 nt
  buffer_load_dwordx4 v[176:179], v4, s[24:27], s52 offen offset:0 nt
  buffer_load_dwordx4 v[192:195], v4, s[24:27], s53 offen offset:0 nt
  buffer_load_dwordx4 v[180:183], v4, s[24:27], s52 offen offset:2048 nt
  buffer_load_dwordx4 v[196:199], v4, s[24:27], s53 offen offset:2048 nt
  buffer_load_dwordx4 v[184:187], v5, s[24:27], s52 offen offset:0 nt
  buffer_load_dwordx4 v[200:203], v5, s[24:27], s53 offen offset:0 nt
  buffer_load_dwordx4 v[188:191], v5, s[24:27], s52 offen offset:2048 nt
  buffer_load_dwordx4 v[204:207], v5, s[24:27], s53 offen offset:2048 nt
  buffer_load_dword v78, v17, s[28:31], s4 offen
  buffer_load_dword v78, v17, s[28:31], s18 offen
  s_waitcnt vmcnt(24)
  v_perm_b32 v80, v128, v112, s68
  v_perm_b32 v96, v130, v114, s68
  v_perm_b32 v84, v128, v112, s69
  v_perm_b32 v100, v130, v114, s69
  v_perm_b32 v88, v129, v113, s68
  v_perm_b32 v104, v131, v115, s68
  v_perm_b32 v92, v129, v113, s69
  v_perm_b32 v108, v131, v115, s69
  s_waitcnt vmcnt(22)
  v_perm_b32 v81, v132, v116, s68
  v_perm_b32 v97, v134, v118, s68
  v_perm_b32 v85, v132, v116, s69
  v_perm_b32 v101, v134, v118, s69
  v_perm_b32 v89, v133, v117, s68
  v_perm_b32 v105, v135, v119, s68
  v_perm_b32 v93, v133, v117, s69
  v_perm_b32 v109, v135, v119, s69
  s_waitcnt vmcnt(20)
  v_perm_b32 v82, v136, v120, s68
  v_perm_b32 v98, v138, v122, s68
  v_perm_b32 v86, v136, v120, s69
  v_perm_b32 v102, v138, v122, s69
  v_perm_b32 v90, v137, v121, s68
  v_perm_b32 v106, v139, v123, s68
  v_perm_b32 v94, v137, v121, s69
  v_perm_b32 v110, v139, v123, s69
  s_waitcnt vmcnt(18)
  v_perm_b32 v83, v140, v124, s68
  v_perm_b32 v99, v142, v126, s68
  v_perm_b32 v87, v140, v124, s69
  v_mfma_f32_16x16x32_bf16 v[64:67], v[48:51], v[80:83], v[64:67]
  v_perm_b32 v103, v142, v126, s69
  v_mfma_f32_16x16x32_bf16 v[68:71], v[48:51], v[96:99], v[68:71]
  v_perm_b32 v91, v141, v125, s68
  v_mfma_f32_16x16x32_bf16 v[64:67], v[52:55], v[84:87], v[64:67]
  v_perm_b32 v107, v143, v127, s68
  v_mfma_f32_16x16x32_bf16 v[68:71], v[52:55], v[100:103], v[68:71]
  v_perm_b32 v95, v141, v125, s69
  v_mfma_f32_16x16x32_bf16 v[64:67], v[56:59], v[88:91], v[64:67]
  v_perm_b32 v111, v143, v127, s69
  v_mfma_f32_16x16x32_bf16 v[68:71], v[56:59], v[104:107], v[68:71]
  s_nop 0
  v_mfma_f32_16x16x32_bf16 v[64:67], v[60:63], v[92:95], v[64:67]
  v_mfma_f32_16x16x32_bf16 v[68:71], v[60:63], v[108:111], v[68:71]
  v_mov_b32_dpp v48, v33 quad_perm:[0,1,2,3] row_mask:0xf bank_mask:0x1
  v_mov_b32_dpp v49, v33 row_shl:4 row_mask:0xf bank_mask:0x1
  v_mov_b32_dpp v50, v33 row_shl:8 row_mask:0xf bank_mask:0x1
  v_mov_b32_dpp v51, v33 row_shl:12 row_mask:0xf bank_mask:0x1
  v_mov_b32_dpp v52, v33 row_shr:4 row_mask:0xf bank_mask:0x2
  v_mov_b32_dpp v53, v33 quad_perm:[0,1,2,3] row_mask:0xf bank_mask:0x2
  v_mov_b32_dpp v54, v33 row_shl:4 row_mask:0xf bank_mask:0x2
  v_mov_b32_dpp v55, v33 row_shl:8 row_mask:0xf bank_mask:0x2
  v_mov_b32_dpp v56, v33 row_shr:8 row_mask:0xf bank_mask:0x4
  v_mov_b32_dpp v57, v33 row_shr:4 row_mask:0xf bank_mask:0x4
  v_mov_b32_dpp v58, v33 quad_perm:[0,1,2,3] row_mask:0xf bank_mask:0x4
  v_mov_b32_dpp v59, v33 row_shl:4 row_mask:0xf bank_mask:0x4
  v_mov_b32_dpp v60, v33 row_shr:12 row_mask:0xf bank_mask:0x8
  v_mov_b32_dpp v61, v33 row_shr:8 row_mask:0xf bank_mask:0x8
  v_mov_b32_dpp v62, v33 row_shr:4 row_mask:0xf bank_mask:0x8
  v_mov_b32_dpp v63, v33 quad_perm:[0,1,2,3] row_mask:0xf bank_mask:0x8
  s_waitcnt vmcnt(16)
  v_perm_b32 v80, v160, v144, s68
  v_perm_b32 v96, v162, v146, s68
  v_perm_b32 v84, v160, v144, s69
  v_perm_b32 v100, v162, v146, s69
  v_perm_b32 v88, v161, v145, s68
  v_perm_b32 v104, v163, v147, s68
  v_perm_b32 v92, v161, v145, s69
  v_perm_b32 v108, v163, v147, s69
  s_waitcnt vmcnt(14)
  v_perm_b32 v81, v164, v148, s68
  v_perm_b32 v97, v166, v150, s68
  v_perm_b32 v85, v164, v148, s69
  v_perm_b32 v101, v166, v150, s69
  v_perm_b32 v89, v165, v149, s68
  v_perm_b32 v105, v167, v151, s68
  v_perm_b32 v93, v165, v149, s69
  v_perm_b32 v109, v167, v151, s69
  s_waitcnt vmcnt(12)
  v_perm_b32 v82, v168, v152, s68
  v_perm_b32 v98, v170, v154, s68
  v_perm_b32 v86, v168, v152, s69
  v_perm_b32 v102, v170, v154, s69
  v_perm_b32 v90, v169, v153, s68
  v_perm_b32 v106, v171, v155, s68
  v_perm_b32 v94, v169, v153, s69
  v_perm_b32 v110, v171, v155, s69
  s_waitcnt vmcnt(10)
  v_perm_b32 v83, v172, v156, s68
  v_perm_b32 v99, v174, v158, s68
  v_perm_b32 v87, v172, v156, s69
  v_mfma_f32_16x16x32_bf16 v[64:67], v[48:51], v[80:83], v[64:67]
  v_perm_b32 v103, v174, v158, s69
  v_mfma_f32_16x16x32_bf16 v[68:71], v[48:51], v[96:99], v[68:71]
  v_perm_b32 v91, v173, v157, s68
  v_mfma_f32_16x16x32_bf16 v[64:67], v[52:55], v[84:87], v[64:67]
  v_perm_b32 v107, v175, v159, s68
  v_mfma_f32_16x16x32_bf16 v[68:71], v[52:55], v[100:103], v[68:71]
  v_perm_b32 v95, v173, v157, s69
  v_mfma_f32_16x16x32_bf16 v[64:67], v[56:59], v[88:91], v[64:67]
  v_perm_b32 v111, v175, v159, s69
  v_mfma_f32_16x16x32_bf16 v[68:71], v[56:59], v[104:107], v[68:71]
  s_nop 0
  v_mfma_f32_16x16x32_bf16 v[64:67], v[60:63], v[92:95], v[64:67]
  v_mfma_f32_16x16x32_bf16 v[68:71], v[60:63], v[108:111], v[68:71]
  s_mul_i32 s70, s45, 6
  s_add_u32 s70, s70, s59
  s_cmp_lt_u32 s70, s75
  s_cselect_b32 s71, 1, s46
  s_cmp_lg_u32 s71, 0
  s_cbranch_scc1 L_no_early
  s_waitcnt lgkmcnt(0)
  s_barrier
  ds_read_b128 v[124:127], v16
  ds_read_b128 v[128:131], v16 offset:128
  ds_read_b128 v[112:115], v15 offset:512
  ds_read_b128 v[116:119], v15 offset:2560
  ds_read_b128 v[120:123], v15 offset:4608
  s_waitcnt lgkmcnt(4)
  v_max3_f32 v46, v124, v125, v126
  v_max_f32 v46, v46, v127
  v_sub_f32 v124, v124, v46
  v_sub_f32 v125, v125, v46
  v_sub_f32 v126, v126, v46
  v_sub_f32 v127, v127, v46
  v_exp_f32 v124, v124
  v_exp_f32 v125, v125
  v_exp_f32 v126, v126
  v_exp_f32 v127, v127
  s_waitcnt lgkmcnt(2)
  v_mul_f32 v47, v124, v128
  v_pk_mul_f32 v[72:73], v[112:113], v[124:125] op_sel_hi:[1,0]
  v_pk_mul_f32 v[74:75], v[114:115], v[124:125] op_sel_hi:[1,0]
  s_waitcnt lgkmcnt(1)
  v_fmac_f32 v47, v125, v129
  v_pk_fma_f32 v[72:73], v[116:117], v[124:125], v[72:73] op_sel:[0,1,0]
  v_pk_fma_f32 v[74:75], v[118:119], v[124:125], v[74:75] op_sel:[0,1,0]
  s_waitcnt lgkmcnt(0)
  v_fmac_f32 v47, v126, v130
  v_pk_fma_f32 v[72:73], v[120:121], v[126:127], v[72:73] op_sel_hi:[1,0,1]
  v_pk_fma_f32 v[74:75], v[122:123], v[126:127], v[74:75] op_sel_hi:[1,0,1]
  v_fmac_f32 v47, v127, v131
  v_mov_b32 v210, v127
  s_cmp_lg_u32 s77, 0
  s_cselect_b64 vcc, 0, s[72:73]
  v_cndmask_b32 v210, v210, 0, vcc
  v_cndmask_b32 v72, v72, v46, vcc
  v_cndmask_b32 v73, v73, v47, vcc
L_no_early:
  v_mov_b32_dpp v48, v34 quad_perm:[0,1,2,3] row_mask:0xf bank_mask:0x1
  v_mov_b32_dpp v49, v34 row_shl:4 row_mask:0xf bank_mask:0x1
  v_mov_b32_dpp v50, v34 row_shl:8 row_mask:0xf bank_mask:0x1
  v_mov_b32_dpp v51, v34 row_shl:12 row_mask:0xf bank_mask:0x1
  v_mov_b32_dpp v52, v34 row_shr:4 row_mask:0xf bank_mask:0x2
  v_mov_b32_dpp v53, v34 quad_perm:[0,1,2,3] row_mask:0xf bank_mask:0x2
  v_mov_b32_dpp v54, v34 row_shl:4 row_mask:0xf bank_mask:0x2
  v_mov_b32_dpp v55, v34 row_shl:8 row_mask:0xf bank_mask:0x2
  v_mov_b32_dpp v56, v34 row_shr:8 row_mask:0xf bank_mask:0x4
  v_mov_b32_dpp v57, v34 row_shr:4 row_mask:0xf bank_mask:0x4
  v_mov_b32_dpp v58, v34 quad_perm:[0,1,2,3] row_mask:0xf bank_mask:0x4
  v_mov_b32_dpp v59, v34 row_shl:4 row_mask:0xf bank_mask:0x4
  v_mov_b32_dpp v60, v34 row_shr:12 row_mask:0xf bank_mask:0x8
  v_mov_b32_dpp v61, v34 row_shr:8 row_mask:0xf bank_mask:0x8
  v_mov_b32_dpp v62, v34 row_shr:4 row_mask:0xf bank_mask:0x8
  v_mov_b32_dpp v63, v34 quad_perm:[0,1,2,3] row_mask:0xf bank_mask:0x8
  s_waitcnt vmcnt(8)
  v_perm_b32 v80, v192, v176, s68
  v_perm_b32 v96, v194, v178, s68
  v_perm_b32 v84, v192, v176, s69
  v_perm_b32 v100, v194, v178, s69
  v_perm_b32 v88, v193, v177, s68
  v_perm_b32 v104, v195, v179, s68
  v_perm_b32 v92, v193, v177, s69
  v_perm_b32 v108, v195, v179, s69
  s_waitcnt vmcnt(6)
  v_perm_b32 v81, v196, v180, s68
  v_perm_b32 v97, v198, v182, s68
  v_perm_b32 v85, v196, v180, s69
  v_perm_b32 v101, v198, v182, s69
  v_perm_b32 v89, v197, v181, s68
  v_perm_b32 v105, v199, v183, s68
  v_perm_b32 v93, v197, v181, s69
  v_perm_b32 v109, v199, v183, s69
  s_waitcnt vmcnt(4)
  v_perm_b32 v82, v200, v184, s68
  v_perm_b32 v98, v202, v186, s68
  v_perm_b32 v86, v200, v184, s69
  v_perm_b32 v102, v202, v186, s69
  v_perm_b32 v90, v201, v185, s68
  v_perm_b32 v106, v203, v187, s68
  v_perm_b32 v94, v201, v185, s69
  v_perm_b32 v110, v203, v187, s69
  s_waitcnt vmcnt(2)
  v_perm_b32 v83, v204, v188, s68
  v_perm_b32 v99, v206, v190, s68
  v_perm_b32 v87, v204, v188, s69
  v_mfma_f32_16x16x32_bf16 v[64:67], v[48:51], v[80:83], v[64:67]
  v_perm_b32 v103, v206, v190, s69
  v_mfma_f32_16x16x32_bf16 v[68:71], v[48:51], v[96:99], v[68:71]
  v_perm_b32 v91, v205, v189, s68
  v_mfma_f32_16x16x32_bf16 v[64:67], v[52:55], v[84:87], v[64:67]
  v_perm_b32 v107, v207, v191, s68
  v_mfma_f32_16x16x32_bf16 v[68:71], v[52:55], v[100:103], v[68:71]
  v_perm_b32 v95, v205, v189, s69
  v_mfma_f32_16x16x32_bf16 v[64:67], v[56:59], v[88:91], v[64:67]
  v_perm_b32 v111, v207, v191, s69
  v_mfma_f32_16x16x32_bf16 v[68:71], v[56:59], v[104:107], v[68:71]
  s_nop 0
  v_mfma_f32_16x16x32_bf16 v[64:67], v[60:63], v[92:95], v[64:67]
  v_mfma_f32_16x16x32_bf16 v[68:71], v[60:63], v[108:111], v[68:71]
  s_cmp_lt_u32 s70, s75
  s_cbranch_scc1 L_next_round
  s_nop 1
  s_mov_b32 s65, s4
  s_mov_b32 s19, 0
  s_mov_b32 s3, 0x40000
  s_cmp_eq_u32 s46, 0
  ds_write2st64_b32 v14, v64, v68 offset0:0 offset1:1
  ds_write2st64_b32 v14, v65, v69 offset0:2 offset1:3
  ds_write2st64_b32 v14, v66, v70 offset0:4 offset1:5
  ds_write2st64_b32 v14, v67, v71 offset0:6 offset1:7
  s_cbranch_scc0 L_others
L_b2:
  s_waitcnt lgkmcnt(0)
  s_barrier
  ds_read_b128 v[112:115], v15 offset:6656
  ds_read_b32 v88, v45 offset:255
  s_cmp_lg_u32 s77, 0
  s_waitcnt lgkmcnt(1)
  v_pk_fma_f32 v[72:73], v[112:113], v[210:211], v[72:73] op_sel_hi:[1,0,1]
  v_pk_fma_f32 v[74:75], v[114:115], v[210:211], v[74:75] op_sel_hi:[1,0,1]
  s_cbranch_scc1 L_consumer
  buffer_store_dwordx4 v[72:75], v17, s[28:31], s65 offen
  s_branch L_published
L_others:
  s_cmp_lg_u32 s12, 0
  s_cbranch_scc1 L_str
  s_waitcnt lgkmcnt(0)
  s_barrier
  ds_read_b128 v[124:127], v16
  ds_read_b128 v[128:131], v16 offset:128
  ds_read_b128 v[112:115], v15 offset:512
  ds_read_b128 v[116:119], v15 offset:2560
  ds_read_b128 v[120:123], v15 offset:4608
  s_waitcnt lgkmcnt(4)
  v_max3_f32 v46, v124, v125, v126
  v_max_f32 v46, v46, v127
  v_sub_f32 v124, v124, v46
  v_sub_f32 v125, v125, v46
  v_sub_f32 v126, v126, v46
  v_sub_f32 v127, v127, v46
  v_exp_f32 v124, v124
  v_exp_f32 v125, v125
  v_exp_f32 v126, v126
  v_exp_f32 v127, v127
  s_waitcnt lgkmcnt(2)
  v_mul_f32 v47, v124, v128
  v_pk_mul_f32 v[72:73], v[112:113], v[124:125] op_sel_hi:[1,0]
  v_pk_mul_f32 v[74:75], v[114:115], v[124:125] op_sel_hi:[1,0]
  s_waitcnt lgkmcnt(1)
  v_fmac_f32 v47, v125, v129
  v_pk_fma_f32 v[72:73], v[116:117], v[124:125], v[72:73] op_sel:[0,1,0]
  v_pk_fma_f32 v[74:75], v[118:119], v[124:125], v[74:75] op_sel:[0,1,0]
  s_waitcnt lgkmcnt(0)
  v_fmac_f32 v47, v126, v130
  v_pk_fma_f32 v[72:73], v[120:121], v[126:127], v[72:73] op_sel_hi:[1,0,1]
  v_pk_fma_f32 v[74:75], v[122:123], v[126:127], v[74:75] op_sel_hi:[1,0,1]
  v_fmac_f32 v47, v127, v131
  v_mov_b32 v210, v127
  s_cmp_lg_u32 s77, 0
  s_cselect_b64 vcc, 0, s[72:73]
  v_cndmask_b32 v210, v210, 0, vcc
  v_cndmask_b32 v72, v72, v46, vcc
  v_cndmask_b32 v73, v73, v47, vcc
  s_cmp_lg_u32 s40, 0
  s_cbranch_scc1 L_b2
  buffer_load_ubyte v12, v79, s[32:35], s9 offen nt
  s_waitcnt vmcnt(0)
  v_and_b32 v12, 0xbf, v12
  v_cmp_eq_u32 vcc, s78, v12
  s_nop 1
  v_mov_b32 v39, vcc_lo
  ds_write_b32 v45, v39 offset:255
  s_branch L_b2
L_str:
  s_cmp_lg_u32 s40, 0
  s_cbranch_scc1 L_nopeek
  buffer_load_ubyte v12, v79, s[32:35], s9 offen nt
  s_waitcnt vmcnt(0)
  v_and_b32 v12, 0xbf, v12
  v_cmp_eq_u32 vcc, s78, v12
  s_nop 1
  v_mov_b32 v39, vcc_lo
  ds_write_b32 v45, v39 offset:255
L_nopeek:
  s_waitcnt lgkmcnt(0)
  s_barrier
  s_branch L_seg1_first
L_reduce:
  ds_read_b128 v[80:83], v16
  ds_read_b128 v[84:87], v16 offset:128
  ds_read_b128 v[112:115], v15 offset:512
  ds_read_b128 v[116:119], v15 offset:2560
  ds_read_b128 v[120:123], v15 offset:4608
  ds_read_b128 v[124:127], v15 offset:6656
  ds_read_b32 v88, v45 offset:255
  s_waitcnt lgkmcnt(6)
  v_max3_f32 v46, v80, v81, v82
  v_max_f32 v46, v46, v83
  v_sub_f32 v80, v80, v46
  v_sub_f32 v81, v81, v46
  v_sub_f32 v82, v82, v46
  v_sub_f32 v83, v83, v46
  v_exp_f32 v80, v80
  v_exp_f32 v81, v81
  v_exp_f32 v82, v82
  v_exp_f32 v83, v83
  s_waitcnt lgkmcnt(4)
  v_mul_f32 v47, v80, v84
  v_pk_mul_f32 v[72:73], v[112:113], v[80:81] op_sel_hi:[1,0]
  v_pk_mul_f32 v[74:75], v[114:115], v[80:81] op_sel_hi:[1,0]
  s_waitcnt lgkmcnt(3)
  v_fmac_f32 v47, v81, v85
  v_pk_fma_f32 v[72:73], v[116:117], v[80:81], v[72:73] op_sel:[0,1,0]
  v_pk_fma_f32 v[74:75], v[118:119], v[80:81], v[74:75] op_sel:[0,1,0]
  s_waitcnt lgkmcnt(2)
  v_fmac_f32 v47, v82, v86
  v_pk_fma_f32 v[72:73], v[120:121], v[82:83], v[72:73] op_sel_hi:[1,0,1]
  v_pk_fma_f32 v[74:75], v[122:123], v[82:83], v[74:75] op_sel_hi:[1,0,1]
  s_waitcnt lgkmcnt(1)
  v_fmac_f32 v47, v83, v87
  v_pk_fma_f32 v[72:73], v[124:125], v[82:83], v[72:73] op_sel:[0,1,0]
  v_pk_fma_f32 v[74:75], v[126:127], v[82:83], v[74:75] op_sel:[0,1,0]
  v_cndmask_b32 v72, v72, v46, s[72:73]
  v_cndmask_b32 v73, v73, v47, s[72:73]
  buffer_store_dwordx4 v[72:75], v17, s[28:31], s65 offen
L_published:
  s_waitcnt lgkmcnt(0)
  v_readfirstlane_b32 s13, v88
  s_or_b32 s71, s6, s7
  s_nop 2
  s_andn2_b32 s70, s71, s13
  s_cbranch_scc1 L_pubB
L_pub_done:
  s_cmp_lg_u32 s19, 0
  s_cbranch_scc1 L_seg1_back
  s_branch L_fin
L_consumer:
  s_waitcnt lgkmcnt(0)
  v_readfirstlane_b32 s13, v88
  s_nop 3
  s_andn2_b32 s70, s6, s13
  s_cbranch_scc1 L_slow
L_pollA:
  buffer_load_dwordx2 v[76:77], v35, s[28:31], s60 offen offset:0 sc1
  buffer_load_dwordx4 v[128:131], v40, s[28:31], s60 offen offset:0 sc1
  buffer_load_dwordx4 v[132:135], v41, s[28:31], s61 offen offset:0 sc1
  buffer_load_dwordx4 v[136:139], v42, s[28:31], s62 offen offset:0 sc1
  buffer_load_dwordx4 v[140:143], v43, s[28:31], s63 offen offset:0 sc1
  buffer_load_dwordx4 v[144:147], v44, s[28:31], s64 offen offset:0 sc1
L_ploop:
  buffer_load_dwordx2 v[172:173], v35, s[28:31], s60 offen offset:0 sc1
  buffer_load_dwordx4 v[152:155], v40, s[28:31], s60 offen offset:0 sc1
  buffer_load_dwordx4 v[156:159], v41, s[28:31], s61 offen offset:0 sc1
  buffer_load_dwordx4 v[160:163], v42, s[28:31], s62 offen offset:0 sc1
  buffer_load_dwordx4 v[164:167], v43, s[28:31], s63 offen offset:0 sc1
  buffer_load_dwordx4 v[168:171], v44, s[28:31], s64 offen offset:0 sc1
  s_waitcnt vmcnt(11)
  v_max_u32 v39, v76, v77
  s_waitcnt vmcnt(10)
  v_max3_u32 v39, v39, v128, v129
  v_max3_u32 v39, v39, v130, v131
  s_waitcnt vmcnt(9)
  v_max3_u32 v39, v39, v132, v133
  v_max3_u32 v39, v39, v134, v135
  s_waitcnt vmcnt(8)
  v_max3_u32 v39, v39, v136, v137
  v_max3_u32 v39, v39, v138, v139
  s_waitcnt vmcnt(7)
  v_max3_u32 v39, v39, v140, v141
  v_max3_u32 v39, v39, v142, v143
  s_waitcnt vmcnt(6)
  v_max3_u32 v39, v39, v144, v145
  v_max3_u32 v39, v39, v146, v147
  v_cmp_ne_u32 vcc, -1, v39
  v_cndmask_b32 v76, v7, v76, s[14:15]
  v_cndmask_b32 v76, v76, v46, s[16:17]
  s_cmp_eq_u64 vcc, -1
  s_cbranch_scc1 L_math
  buffer_load_dwordx2 v[76:77], v35, s[28:31], s60 offen offset:0 sc1
  buffer_load_dwordx4 v[128:131], v40, s[28:31], s60 offen offset:0 sc1
  buffer_load_dwordx4 v[132:135], v41, s[28:31], s61 offen offset:0 sc1
  buffer_load_dwordx4 v[136:139], v42, s[28:31], s62 offen offset:0 sc1
  buffer_load_dwordx4 v[140:143], v43, s[28:31], s63 offen offset:0 sc1
  buffer_load_dwordx4 v[144:147], v44, s[28:31], s64 offen offset:0 sc1
  s_waitcnt vmcnt(11)
  v_max_u32 v39, v172, v173
  s_waitcnt vmcnt(10)
  v_max3_u32 v39, v39, v152, v153
  v_max3_u32 v39, v39, v154, v155
  s_waitcnt vmcnt(9)
  v_max3_u32 v39, v39, v156, v157
  v_max3_u32 v39, v39, v158, v159
  s_waitcnt vmcnt(8)
  v_max3_u32 v39, v39, v160, v161
  v_max3_u32 v39, v39, v162, v163
  s_waitcnt vmcnt(7)
  v_max3_u32 v39, v39, v164, v165
  v_max3_u32 v39, v39, v166, v167
  s_waitcnt vmcnt(6)
  v_max3_u32 v39, v39, v168, v169
  v_max3_u32 v39, v39, v170, v171
  v_cmp_ne_u32 vcc, -1, v39
  v_cndmask_b32 v172, v7, v172, s[14:15]
  v_cndmask_b32 v172, v172, v46, s[16:17]
  s_cmp_eq_u64 vcc, -1
  s_cbranch_scc1 L_math1
  s_sub_u32 s3, s3, 1
  s_cmp_gt_i32 s3, 0
  s_cbranch_scc1 L_ploop
L_math1:
  v_mov_b32 v36, v172
  v_cndmask_b32 v173, v173, v47, s[16:17]
  s_nop 0
  v_max_f32_dpp v36, v36, v36 row_ror:1 row_mask:0xf bank_mask:0xf
  s_nop 1
  v_max_f32_dpp v36, v36, v36 row_ror:2 row_mask:0xf bank_mask:0xf
  s_nop 1
  v_max_f32_dpp v36, v36, v36 row_ror:4 row_mask:0xf bank_mask:0xf
  v_mov_b32 v37, v36
  s_nop 1
  v_permlane32_swap_b32 v36, v37
  v_max_f32 v36, v36, v37
  v_sub_f32 v172, v172, v36
  v_sub_f32 v38, v46, v36
  v_exp_f32 v172, v172
  v_exp_f32 v38, v38
  v_mul_f32 v36, v172, v173
  v_mul_f32 v38, v38, v19
  v_mul_f32 v96, v72, v38
  v_mul_f32 v97, v73, v38
  v_add_f32_dpp v36, v36, v36 row_ror:1 row_mask:0xf bank_mask:0xf
  v_mul_f32 v98, v74, v38
  v_mul_f32 v99, v75, v38
  v_add_f32_dpp v36, v36, v36 row_ror:2 row_mask:0xf bank_mask:0xf
  v_fmac_f32_dpp v96, v172, v152 row_newbcast:0 row_mask:0xf bank_mask:0xf
  v_fmac_f32_dpp v97, v172, v153 row_newbcast:0 row_mask:0xf bank_mask:0xf
  v_add_f32_dpp v36, v36, v36 row_ror:4 row_mask:0xf bank_mask:0xf
  v_mov_b32 v37, v36
  v_fmac_f32_dpp v98, v172, v154 row_newbcast:0 row_mask:0xf bank_mask:0xf
  v_fmac_f32_dpp v99, v172, v155 row_newbcast:0 row_mask:0xf bank_mask:0xf
  v_permlane32_swap_b32 v36, v37
  v_add_f32 v36, v36, v37
  v_rcp_f32 v36, v36
  v_fmac_f32_dpp v96, v172, v156 row_newbcast:1 row_mask:0xf bank_mask:0xf
  v_fmac_f32_dpp v97, v172, v157 row_newbcast:1 row_mask:0xf bank_mask:0xf
  v_fmac_f32_dpp v98, v172, v158 row_newbcast:1 row_mask:0xf bank_mask:0xf
  v_fmac_f32_dpp v99, v172, v159 row_newbcast:1 row_mask:0xf bank_mask:0xf
  v_fmac_f32_dpp v96, v172, v160 row_newbcast:2 row_mask:0xf bank_mask:0xf
  v_fmac_f32_dpp v97, v172, v161 row_newbcast:2 row_mask:0xf bank_mask:0xf
  v_fmac_f32_dpp v98, v172, v162 row_newbcast:2 row_mask:0xf bank_mask:0xf
  v_fmac_f32_dpp v99, v172, v163 row_newbcast:2 row_mask:0xf bank_mask:0xf
  v_fmac_f32_dpp v96, v172, v164 row_newbcast:3 row_mask:0xf bank_mask:0xf
  v_fmac_f32_dpp v97, v172, v165 row_newbcast:3 row_mask:0xf bank_mask:0xf
  v_fmac_f32_dpp v98, v172, v166 row_newbcast:3 row_mask:0xf bank_mask:0xf
  v_fmac_f32_dpp v99, v172, v167 row_newbcast:3 row_mask:0xf bank_mask:0xf
  v_fmac_f32_dpp v96, v172, v168 row_newbcast:4 row_mask:0xf bank_mask:0xf
  v_fmac_f32_dpp v97, v172, v169 row_newbcast:4 row_mask:0xf bank_mask:0xf
  v_fmac_f32_dpp v98, v172, v170 row_newbcast:4 row_mask:0xf bank_mask:0xf
  v_fmac_f32_dpp v99, v172, v171 row_newbcast:4 row_mask:0xf bank_mask:0xf
  s_nop 1
  v_permlane32_swap_b32 v96, v98
  v_permlane32_swap_b32 v97, v99
  v_add_f32 v96, v96, v98
  v_add_f32 v97, v97, v99
  v_mul_f32 v96, v96, v36
  v_mul_f32 v97, v97, v36
  v_cvt_pk_bf16_f32 v96, v96, v97
  buffer_store_dword v96, v18, s[36:39], s8 offen
  s_branch L_fin
L_math:
  v_mov_b32 v36, v76
  v_cndmask_b32 v77, v77, v47, s[16:17]
  s_nop 0
  v_max_f32_dpp v36, v36, v36 row_ror:1 row_mask:0xf bank_mask:0xf
  s_nop 1
  v_max_f32_dpp v36, v36, v36 row_ror:2 row_mask:0xf bank_mask:0xf
  s_nop 1
  v_max_f32_dpp v36, v36, v36 row_ror:4 row_mask:0xf bank_mask:0xf
  v_mov_b32 v37, v36
  s_nop 1
  v_permlane32_swap_b32 v36, v37
  v_max_f32 v36, v36, v37
  v_sub_f32 v76, v76, v36
  v_sub_f32 v38, v46, v36
  v_exp_f32 v76, v76
  v_exp_f32 v38, v38
  v_mul_f32 v36, v76, v77
  v_mul_f32 v38, v38, v19
  v_mul_f32 v96, v72, v38
  v_mul_f32 v97, v73, v38
  v_add_f32_dpp v36, v36, v36 row_ror:1 row_mask:0xf bank_mask:0xf
  v_mul_f32 v98, v74, v38
  v_mul_f32 v99, v75, v38
  v_add_f32_dpp v36, v36, v36 row_ror:2 row_mask:0xf bank_mask:0xf
  v_fmac_f32_dpp v96, v76, v128 row_newbcast:0 row_mask:0xf bank_mask:0xf
  v_fmac_f32_dpp v97, v76, v129 row_newbcast:0 row_mask:0xf bank_mask:0xf
  v_add_f32_dpp v36, v36, v36 row_ror:4 row_mask:0xf bank_mask:0xf
  v_mov_b32 v37, v36
  v_fmac_f32_dpp v98, v76, v130 row_newbcast:0 row_mask:0xf bank_mask:0xf
  v_fmac_f32_dpp v99, v76, v131 row_newbcast:0 row_mask:0xf bank_mask:0xf
  v_permlane32_swap_b32 v36, v37
  v_add_f32 v36, v36, v37
  v_rcp_f32 v36, v36
  v_fmac_f32_dpp v96, v76, v132 row_newbcast:1 row_mask:0xf bank_mask:0xf
  v_fmac_f32_dpp v97, v76, v133 row_newbcast:1 row_mask:0xf bank_mask:0xf
  v_fmac_f32_dpp v98, v76, v134 row_newbcast:1 row_mask:0xf bank_mask:0xf
  v_fmac_f32_dpp v99, v76, v135 row_newbcast:1 row_mask:0xf bank_mask:0xf
  v_fmac_f32_dpp v96, v76, v136 row_newbcast:2 row_mask:0xf bank_mask:0xf
  v_fmac_f32_dpp v97, v76, v137 row_newbcast:2 row_mask:0xf bank_mask:0xf
  v_fmac_f32_dpp v98, v76, v138 row_newbcast:2 row_mask:0xf bank_mask:0xf
  v_fmac_f32_dpp v99, v76, v139 row_newbcast:2 row_mask:0xf bank_mask:0xf
  v_fmac_f32_dpp v96, v76, v140 row_newbcast:3 row_mask:0xf bank_mask:0xf
  v_fmac_f32_dpp v97, v76, v141 row_newbcast:3 row_mask:0xf bank_mask:0xf
  v_fmac_f32_dpp v98, v76, v142 row_newbcast:3 row_mask:0xf bank_mask:0xf
  v_fmac_f32_dpp v99, v76, v143 row_newbcast:3 row_mask:0xf bank_mask:0xf
  v_fmac_f32_dpp v96, v76, v144 row_newbcast:4 row_mask:0xf bank_mask:0xf
  v_fmac_f32_dpp v97, v76, v145 row_newbcast:4 row_mask:0xf bank_mask:0xf
  v_fmac_f32_dpp v98, v76, v146 row_newbcast:4 row_mask:0xf bank_mask:0xf
  v_fmac_f32_dpp v99, v76, v147 row_newbcast:4 row_mask:0xf bank_mask:0xf
  s_nop 1
  v_permlane32_swap_b32 v96, v98
  v_permlane32_swap_b32 v97, v99
  v_add_f32 v96, v96, v98
  v_add_f32 v97, v97, v99
  v_mul_f32 v96, v96, v36
  v_mul_f32 v97, v97, v36
  v_cvt_pk_bf16_f32 v96, v96, v97
  buffer_store_dword v96, v18, s[36:39], s8 offen
L_fin:
L_end:
  s_endpgm
L_repoll:
  s_cmp_gt_i32 s3, 0
  s_cbranch_scc1 L_pollA
  s_branch L_math
L_pubB:
  buffer_store_dwordx4 v[72:75], v17, s[28:31], s65 offen offset:2176 sc1
  s_cmp_lg_u32 s19, 0
  s_waitcnt vmcnt(0)
  s_cbranch_scc1 L_seg1_back
L_slow:
  s_barrier
  s_cmp_lg_u32 s40, 0
  s_cbranch_scc1 L_flagged
  s_or_b32 s70, s78, 0x40
  s_add_u32 s71, s9, s42
  v_mov_b32 v36, s70
  buffer_store_byte v36, v11, s[32:35], s71 offen sc1
L_flagged:
  s_cmp_eq_u32 s77, 0
  s_cbranch_scc1 L_fin
  s_lshl_b32 s71, 1, s42
  s_andn2_b32 s71, s6, s71
L_slow_loop:
  buffer_load_ubyte v37, v79, s[32:35], s9 offen sc1
  s_sub_u32 s3, s3, 1
  s_waitcnt vmcnt(0)
  v_and_b32 v36, 0xbf, v37
  v_and_b32 v37, 0x40, v37
  v_cmp_eq_u32 vcc, s78, v36
  s_nop 3
  s_andn2_b32 s70, s6, vcc_lo
  s_cbranch_scc0 L_pollA
  v_cmp_ne_u32 vcc, 0, v37
  s_nop 3
  s_andn2_b32 s70, s71, vcc_lo
  s_cbranch_scc0 L_loadB
  s_cmp_gt_i32 s3, 0
  s_cbranch_scc1 L_slow_loop
L_loadB:
  buffer_load_dwordx2 v[76:77], v35, s[28:31], s60 offen offset:2176 sc1
  buffer_load_dwordx4 v[128:131], v40, s[28:31], s60 offen offset:2176 sc1
  buffer_load_dwordx4 v[132:135], v41, s[28:31], s61 offen offset:2176 sc1
  buffer_load_dwordx4 v[136:139], v42, s[28:31], s62 offen offset:2176 sc1
  buffer_load_dwordx4 v[140:143], v43, s[28:31], s63 offen offset:2176 sc1
  buffer_load_dwordx4 v[144:147], v44, s[28:31], s64 offen offset:2176 sc1
  s_waitcnt vmcnt(5)
  v_max_u32 v39, v76, v77
  s_waitcnt vmcnt(4)
  v_max3_u32 v39, v39, v128, v129
  v_max3_u32 v39, v39, v130, v131
  s_waitcnt vmcnt(3)
  v_max3_u32 v39, v39, v132, v133
  v_max3_u32 v39, v39, v134, v135
  s_waitcnt vmcnt(2)
  v_max3_u32 v39, v39, v136, v137
  v_max3_u32 v39, v39, v138, v139
  s_waitcnt vmcnt(1)
  v_max3_u32 v39, v39, v140, v141
  v_max3_u32 v39, v39, v142, v143
  s_waitcnt vmcnt(0)
  v_max3_u32 v39, v39, v144, v145
  v_max3_u32 v39, v39, v146, v147
  v_cmp_ne_u32 vcc, -1, v39
  v_cndmask_b32 v76, v7, v76, s[14:15]
  v_cndmask_b32 v76, v76, v46, s[16:17]
  s_cmp_eq_u64 vcc, -1
  s_branch L_math
L_seg1_first:
  v_add_u32 v15, 0x2000, v15
  v_add_u32 v16, 64, v16
  s_mov_b32 s65, s5
  s_mov_b32 s19, 1
  s_branch L_reduce
L_seg1_back:
  v_subrev_u32 v15, 0x2000, v15
  v_subrev_u32 v16, 64, v16
  s_mov_b32 s65, s4
  s_mov_b32 s19, 0
  s_branch L_reduce
L_rescale:
  v_sub_f32 v37, v8, v36
  v_exp_f32 v37, v37
  s_nop 1
  v_mul_f32 v9, v9, v37
  v_readlane_b32 s70, v37, 0
  s_nop 1
  v_mul_f32 v64, s70, v64
  v_mul_f32 v68, s70, v68
  v_readlane_b32 s70, v37, 1
  s_nop 1
  v_mul_f32 v65, s70, v65
  v_mul_f32 v69, s70, v69
  v_readlane_b32 s70, v37, 2
  s_nop 1
  v_mul_f32 v66, s70, v66
  v_mul_f32 v70, s70, v70
  v_readlane_b32 s70, v37, 3
  s_nop 1
  v_mul_f32 v67, s70, v67
  v_mul_f32 v71, s70, v71
  s_branch L_rescale_done
L_next_round:
  s_mov_b32 s76, 1
  s_add_u32 s71, s47, 1016
  s_mov_b32 s59, s70
  s_min_u32 s74, s70, s71
  s_load_dword s53, s[10:11], s74
  s_waitcnt lgkmcnt(0)
  s_add_u32 s70, s70, s45
  s_mov_b32 s58, s70
  s_min_u32 s74, s70, s71
  s_load_dword s52, s[10:11], s74
  s_waitcnt lgkmcnt(0)
  s_add_u32 s70, s70, s45
  s_mov_b32 s57, s70
  s_min_u32 s74, s70, s71
  s_load_dword s51, s[10:11], s74
  s_waitcnt lgkmcnt(0)
  s_add_u32 s70, s70, s45
  s_mov_b32 s56, s70
  s_min_u32 s74, s70, s71
  s_load_dword s50, s[10:11], s74
  s_waitcnt lgkmcnt(0)
  s_add_u32 s70, s70, s45
  s_mov_b32 s55, s70
  s_min_u32 s74, s70, s71
  s_load_dword s49, s[10:11], s74
  s_waitcnt lgkmcnt(0)
  s_add_u32 s70, s70, s45
  s_mov_b32 s54, s70
  s_min_u32 s74, s70, s71
  s_load_dword s48, s[10:11], s74
  s_waitcnt lgkmcnt(0)
  s_add_u32 s70, s70, s45
  s_branch L_round
.section .rodata,"a"
.p2align 6
.amdhsa_kernel standalone__paged_block_table_kv_pagedattention__decode_kernel
  .amdhsa_next_free_vgpr 308
  .amdhsa_next_free_sgpr 80
  .amdhsa_accum_offset 212
  .amdhsa_group_segment_fixed_size 0
  .amdhsa_kernarg_size 64
  .amdhsa_user_sgpr_count 2
  .amdhsa_user_sgpr_kernarg_segment_ptr 1
  .amdhsa_system_sgpr_workgroup_id_x 1
  .amdhsa_float_denorm_mode_32 3
.end_amdhsa_kernel
```
